```python
import torch

def _softmax(x, axis=-1):
    return torch.softmax(x, dim=axis)
def _gelu(x):
    return torch.nn.functional.gelu(x, approximate="tanh")
def _silu(x):
    return torch.nn.functional.silu(x)
def _sigmoid(x):
    return torch.sigmoid(x)
def _layernorm(x, axis=-1, eps=1e-5):
    m = x.mean(dim=axis, keepdim=True)
    v = x.var(dim=axis, keepdim=True, unbiased=False)
    return (x - m) / torch.sqrt(v + eps)
def _scatter_add(tgt, idx, src, axis=0):
    return tgt.clone().index_add_(axis, idx, src)
def _segment_sum(src, seg, n):
    out = torch.zeros((n,) + src.shape[1:], dtype=src.dtype)
    return out.index_add_(0, seg, src)
def _pad(x, pw):
    flat = tuple(v for pair in reversed(pw) for v in pair)
    return torch.nn.functional.pad(x, flat)

kernel_name = 'parallel_sum__sliding_block_cached__dense_activation_silu__decode'

def setup_inputs():

    _w = (lambda a: (lambda t: t.to(torch.bfloat16) if t.is_floating_point() else t)(torch.as_tensor(a)))
    def _A_setup():
        B, Sq, D = 1, 1, 640
        Hq, Hkv, Sk, Dh = 32, 32, 8192, 128
        assert Hq % Hkv == 0, (Hq, Hkv)
        return {
            "x": _w((lambda *s: torch.randn(*s, dtype=torch.bfloat16) * 0.05)(B, Sq, D)),
            "k_cache": _w((lambda *s: torch.randn(*s, dtype=torch.bfloat16) * 3.2)(B, Hkv, Sk, Dh)),
            "v_cache": _w((lambda *s: torch.randn(*s, dtype=torch.bfloat16) * 0.8)(B, Hkv, Sk, Dh)),
            "wq": _w((lambda *s: torch.randn(*s, dtype=torch.bfloat16) * 3.2)(D, Hq * Dh) * (D ** -0.5)),
            "wo": _w((lambda *s: torch.randn(*s, dtype=torch.bfloat16) * 0.8)(Hq * Dh, D) * ((Hq * Dh) ** -0.5)),
        }
    _A_in = _A_setup()

    def _B_setup():
        B, S, D, F = 1, 1, 640, 1728
        return {
            "x": _w((lambda *s: torch.randn(*s, dtype=torch.bfloat16) * 0.05)(B, S, D)),
            "w1": _w((lambda *s: torch.randn(*s, dtype=torch.bfloat16) * 3.2)(D, F) * (D ** -0.5)),
            "w2": _w((lambda *s: torch.randn(*s, dtype=torch.bfloat16) * 0.2)(F, D) * (F ** -0.5)),
        }
    _B_in = _B_setup()

    return {
        "A_x": _A_in["x"],
        "A_k_cache": _A_in["k_cache"],
        "A_v_cache": _A_in["v_cache"],
        "A_wq": _A_in["wq"],
        "A_wo": _A_in["wo"],
        "B_x": _B_in["x"],
        "B_w1": _B_in["w1"],
        "B_w2": _B_in["w2"],
    }

def reference(A_x, A_k_cache, A_v_cache, A_wq, A_wo, B_x, B_w1, B_w2):
    def _A_ref(x, k_cache, v_cache, wq, wo):
        B, Sq, D = x.shape
        Hq, Dh = 32, 128
        Hkv, Sk = k_cache.shape[1], k_cache.shape[2]
        W = min(4096, max(256, Sk // 4))
        rep = Hq // Hkv
        q = (lambda x, *d: x.permute(*d))((x @ wq).reshape(B, Sq, Hq, Dh), 0, 2, 1, 3)
        k = (lambda x, n, axis: torch.repeat_interleave(x, n, dim=axis))(k_cache[:, :, Sk - W:, :], rep, axis=1)
        v = (lambda x, n, axis: torch.repeat_interleave(x, n, dim=axis))(v_cache[:, :, Sk - W:, :], rep, axis=1)
        scores = torch.einsum("bhqd,bhkd->bhqk", q, k) * (Dh ** -0.5)
        p = _softmax(scores, axis=-1)
        o = torch.einsum("bhqk,bhkd->bhqd", p, v)
        return (lambda x, *d: x.permute(*d))(o, 0, 2, 1, 3).reshape(B, Sq, Hq * Dh) @ wo

    def _B_ref(x, w1, w2):
        h = torch.einsum("bsd,df->bsf", x, w1)
        h = _silu(h)
        out = torch.einsum("bsf,fd->bsd", h, w2)
        return out

    x = A_x
    xn = _layernorm(x, axis=-1)
    return x + _A_ref(xn, A_k_cache, A_v_cache, A_wq, A_wo) + _B_ref(xn, B_w1, B_w2)
```

```asm
; @launch grid=(256,1,1) block=(512,1,1) lds=10240
.amdgcn_target "amdgcn-amd-amdhsa--gfx950"
.text
.globl parallel_sum__sliding_block_cached__dense_activation_silu__decode_kernel
.p2align 8
.type parallel_sum__sliding_block_cached__dense_activation_silu__decode_kernel,@function
parallel_sum__sliding_block_cached__dense_activation_silu__decode_kernel:
    s_cmp_ge_u32 s2, 256
    s_cbranch_scc1 L_end
    s_load_dwordx16 s[4:19], s[0:1], 0
    s_load_dwordx4 s[20:23], s[0:1], 64
    s_load_dwordx2 s[24:25], s[0:1], 80
    v_lshrrev_b32 v1, 6, v0
    v_and_b32 v0, 63, v0
    v_readfirstlane_b32 s26, v1
    s_and_b32 s28, s2, 7
    s_lshr_b32 s29, s2, 6
    s_lshl_b32 s29, s29, 3
    s_add_u32 s28, s28, s29
    s_lshr_b32 s29, s2, 3
    s_and_b32 s59, s29, 15
    s_lshl_b32 s59, s59, 12
    s_and_b32 s29, s29, 7
    s_lshr_b32 s52, s2, 6
    s_mul_i32 s52, s52, 3
    s_add_u32 s52, s52, s29
    s_sub_u32 s52, s52, 5
    s_and_b32 s53, s2, 7
    s_lshl_b32 s53, s53, 3
    s_mov_b32 s54, 0x1e140a00
    s_mov_b32 s55, 0x413c3228
    s_mov_b32 s56, 0xa0a0a0a
    s_mov_b32 s57, 0x5050a0a
    s_lshr_b64 s[54:55], s[54:55], s53
    s_lshr_b64 s[56:57], s[56:57], s53
    s_and_b32 s54, s54, 0xff
    s_and_b32 s55, s56, 0xff
    s_add_u32 s54, s54, s52
    s_cmp_lt_u32 s52, s55
    s_cselect_b32 s54, s54, 70
    s_mul_i32 s63, s54, 52429
    s_lshr_b32 s63, s63, 18
    s_mul_i32 s55, s63, 5
    s_sub_u32 s30, s54, s55
    s_and_b32 s27, s26, 3
    s_lshr_b32 s26, s26, 2
    v_and_b32 v1, 15, v0
    v_lshrrev_b32 v2, 4, v0
    v_lshlrev_b32 v3, 4, v0
    s_getreg_b32 s96, hwreg(HW_REG_XCC_ID)
    s_and_b32 s96, s96, 15
    s_waitcnt lgkmcnt(0)
    s_mov_b32 s32, s24
    s_mov_b32 s33, s25
    s_mov_b32 s34, 4194304
    s_mov_b32 s35, 0x20000
    s_cmp_eq_u32 s26, 1
    s_cbranch_scc1 L_B
    s_setprio 3
    buffer_load_dword v9, off, s[32:35], 0 sc1
    s_mov_b32 s36, s4
    s_mov_b32 s37, s5
    s_mov_b32 s38, 1280
    s_mov_b32 s39, 0x20000
    s_cmp_lt_u32 s29, 5
    s_cbranch_scc0 L_A_ffn
    s_lshl_b32 s52, s28, 8
    s_add_u32 s40, s10, s52
    s_addc_u32 s41, s11, 0
    s_sub_u32 s42, 5242880, s52
    s_mov_b32 s43, 0x20000
    s_mov_b32 s53, 8192
    s_mov_b32 s54, 16
    s_lshl_b32 s55, s29, 7
    s_lshl_b32 s52, s27, 5
    s_add_u32 s55, s55, s52
    s_mul_i32 s60, s28, 5
    s_add_u32 s60, s60, s29
    s_lshl_b32 s60, s60, 10
    s_add_u32 s60, s60, 4096
    s_branch L_A_go
L_A_ffn:
    s_cmp_ge_u32 s63, 14
    s_cbranch_scc1 L_A_none
    s_lshl_b32 s52, s63, 8
    s_add_u32 s40, s16, s52
    s_addc_u32 s41, s17, 0
    s_sub_u32 s42, 2211840, s52
    s_mov_b32 s43, 0x20000
    s_mov_b32 s53, 3456
    s_lshl_b32 s55, s30, 7
    s_lshl_b32 s52, s27, 5
    s_add_u32 s55, s55, s52
    s_mul_i32 s60, s63, 5
    s_add_u32 s60, s60, s30
    s_lshl_b32 s60, s60, 10
    s_add_u32 s60, s60, 196608
    s_cmp_eq_u32 s63, 13
    s_cselect_b32 s54, 8, 16
L_A_go:
    s_mov_b32 s97, s60
    v_lshlrev_b32 v14, 3, v2
    v_add_u32 v14, s55, v14
    v_mul_lo_u32 v88, v14, s53
    v_lshlrev_b32 v15, 4, v1
    v_add_u32 v88, v88, v15
    v_cmp_gt_u32 vcc, s54, v1
    v_mov_b32 v15, 0x7ff00000
    s_nop 0
    v_cndmask_b32 v88, v15, v88, vcc
    v_lshlrev_b32 v14, 1, v14
    v_lshlrev_b32 v15, 2, v0
    buffer_load_dwordx4 v[4:7], v3, s[36:39], 0 offen
    buffer_load_dword v8, v15, s[36:39], 0 offen offset:1024
    buffer_load_dwordx4 v[10:13], v14, s[36:39], 0 offen
    s_mov_b32 s52, 0
    buffer_load_dwordx4 v[16:19], v88, s[40:43], s52 offen nt
    s_add_u32 s52, s52, s53
    buffer_load_dwordx4 v[20:23], v88, s[40:43], s52 offen nt
    s_add_u32 s52, s52, s53
    buffer_load_dwordx4 v[24:27], v88, s[40:43], s52 offen nt
    s_add_u32 s52, s52, s53
    buffer_load_dwordx4 v[28:31], v88, s[40:43], s52 offen nt
    s_add_u32 s52, s52, s53
    buffer_load_dwordx4 v[32:35], v88, s[40:43], s52 offen nt
    s_add_u32 s52, s52, s53
    buffer_load_dwordx4 v[36:39], v88, s[40:43], s52 offen nt
    s_add_u32 s52, s52, s53
    buffer_load_dwordx4 v[40:43], v88, s[40:43], s52 offen nt
    s_add_u32 s52, s52, s53
    buffer_load_dwordx4 v[44:47], v88, s[40:43], s52 offen nt
    v_mov_b32 v89, 0
    ds_write_b32 v15, v89
    s_waitcnt lgkmcnt(0)
    s_barrier
    v_and_b32 v90, 1, v0
    v_mov_b32 v91, 0xffff
    v_lshlrev_b32 v90, 4, v90
    v_lshlrev_b32 v91, v90, v91
    v_and_b32 v90, 8, v0
    v_cmp_eq_u32 vcc, 0, v90
    s_nop 1
    v_cndmask_b32 v91, 0, v91, vcc
    v_bfe_u32 v90, v0, 1, 2
    v_cmp_eq_u32 vcc, 0, v90
    s_nop 1
    v_cndmask_b32 v80, 0, v91, vcc
    v_cmp_eq_u32 vcc, 1, v90
    s_nop 1
    v_cndmask_b32 v81, 0, v91, vcc
    v_cmp_eq_u32 vcc, 2, v90
    s_nop 1
    v_cndmask_b32 v82, 0, v91, vcc
    v_cmp_eq_u32 vcc, 3, v90
    s_nop 1
    v_cndmask_b32 v83, 0, v91, vcc
    s_waitcnt vmcnt(8)
    v_add_u32 v9, 0x9e3779b1, v9
    v_or_b32 v9, 1, v9
    v_lshlrev_b32 v90, 16, v4
    v_and_b32 v91, 0xffff0000, v4
    v_lshlrev_b32 v92, 16, v5
    v_and_b32 v93, 0xffff0000, v5
    v_lshlrev_b32 v94, 16, v6
    v_and_b32 v95, 0xffff0000, v6
    v_lshlrev_b32 v96, 16, v7
    v_and_b32 v97, 0xffff0000, v7
    v_lshlrev_b32 v98, 16, v8
    v_and_b32 v99, 0xffff0000, v8
    v_add_f32 v100, v90, v91
    v_add_f32 v101, v92, v93
    v_add_f32 v102, v94, v95
    v_add_f32 v103, v96, v97
    v_add_f32 v104, v98, v99
    v_add_f32 v100, v100, v101
    v_add_f32 v102, v102, v103
    v_add_f32 v100, v100, v104
    v_add_f32 v100, v100, v102
    s_nop 1
    v_add_f32_dpp v100, v100, v100 row_ror:8 row_mask:0xf bank_mask:0xf
    s_nop 1
    v_add_f32_dpp v100, v100, v100 row_ror:4 row_mask:0xf bank_mask:0xf
    s_nop 1
    v_add_f32_dpp v100, v100, v100 row_ror:2 row_mask:0xf bank_mask:0xf
    s_nop 1
    v_add_f32_dpp v100, v100, v100 row_ror:1 row_mask:0xf bank_mask:0xf
    v_mov_b32 v101, v100
    s_nop 1
    v_permlane16_swap_b32 v100, v101
    v_add_f32 v100, v100, v101
    v_mov_b32 v101, v100
    s_nop 1
    v_permlane32_swap_b32 v100, v101
    v_add_f32 v100, v100, v101
    v_mul_f32 v100, 0x3acccccd, v100
    v_sub_f32 v90, v90, v100
    v_sub_f32 v91, v91, v100
    v_sub_f32 v92, v92, v100
    v_sub_f32 v93, v93, v100
    v_sub_f32 v94, v94, v100
    v_sub_f32 v95, v95, v100
    v_sub_f32 v96, v96, v100
    v_sub_f32 v97, v97, v100
    v_sub_f32 v98, v98, v100
    v_sub_f32 v99, v99, v100
    v_mul_f32 v101, v90, v90
    v_mul_f32 v102, v91, v91
    v_fmac_f32 v101, v92, v92
    v_fmac_f32 v102, v93, v93
    v_fmac_f32 v101, v94, v94
    v_fmac_f32 v102, v95, v95
    v_fmac_f32 v101, v96, v96
    v_fmac_f32 v102, v97, v97
    v_fmac_f32 v101, v98, v98
    v_fmac_f32 v102, v99, v99
    v_add_f32 v101, v101, v102
    s_nop 1
    v_add_f32_dpp v101, v101, v101 row_ror:8 row_mask:0xf bank_mask:0xf
    s_nop 1
    v_add_f32_dpp v101, v101, v101 row_ror:4 row_mask:0xf bank_mask:0xf
    s_nop 1
    v_add_f32_dpp v101, v101, v101 row_ror:2 row_mask:0xf bank_mask:0xf
    s_nop 1
    v_add_f32_dpp v101, v101, v101 row_ror:1 row_mask:0xf bank_mask:0xf
    v_mov_b32 v102, v101
    s_nop 1
    v_permlane16_swap_b32 v101, v102
    v_add_f32 v101, v101, v102
    v_mov_b32 v102, v101
    s_nop 1
    v_permlane32_swap_b32 v101, v102
    v_add_f32 v101, v101, v102
    v_mul_f32 v101, 0x3acccccd, v101
    v_cvt_pk_bf16_f32 v102, v100, v101
    v_lshlrev_b32 v100, 16, v102
    v_and_b32 v101, 0xffff0000, v102
    v_add_f32 v101, 0x3727c5ac, v101
    v_cvt_pk_bf16_f32 v101, v101, v101
    v_and_b32 v101, 0xffff0000, v101
    v_sqrt_f32 v101, v101
    s_nop 0
    v_cvt_pk_bf16_f32 v101, v101, v101
    v_and_b32 v101, 0xffff0000, v101
    v_rcp_f32 v101, v101
    v_lshlrev_b32 v90, 16, v10
    v_and_b32 v91, 0xffff0000, v10
    v_lshlrev_b32 v92, 16, v11
    v_and_b32 v93, 0xffff0000, v11
    v_lshlrev_b32 v94, 16, v12
    v_and_b32 v95, 0xffff0000, v12
    v_lshlrev_b32 v96, 16, v13
    v_and_b32 v97, 0xffff0000, v13
    v_sub_f32 v90, v90, v100
    v_sub_f32 v91, v91, v100
    v_sub_f32 v92, v92, v100
    v_sub_f32 v93, v93, v100
    v_sub_f32 v94, v94, v100
    v_sub_f32 v95, v95, v100
    v_sub_f32 v96, v96, v100
    v_sub_f32 v97, v97, v100
    v_cvt_pk_bf16_f32 v90, v90, v90
    v_cvt_pk_bf16_f32 v91, v91, v91
    v_cvt_pk_bf16_f32 v92, v92, v92
    v_cvt_pk_bf16_f32 v93, v93, v93
    v_cvt_pk_bf16_f32 v94, v94, v94
    v_cvt_pk_bf16_f32 v95, v95, v95
    v_cvt_pk_bf16_f32 v96, v96, v96
    v_cvt_pk_bf16_f32 v97, v97, v97
    v_and_b32 v90, 0xffff0000, v90
    v_and_b32 v91, 0xffff0000, v91
    v_and_b32 v92, 0xffff0000, v92
    v_and_b32 v93, 0xffff0000, v93
    v_and_b32 v94, 0xffff0000, v94
    v_and_b32 v95, 0xffff0000, v95
    v_and_b32 v96, 0xffff0000, v96
    v_and_b32 v97, 0xffff0000, v97
    v_mul_f32 v90, v90, v101
    v_mul_f32 v91, v91, v101
    v_mul_f32 v92, v92, v101
    v_mul_f32 v93, v93, v101
    v_mul_f32 v94, v94, v101
    v_mul_f32 v95, v95, v101
    v_mul_f32 v96, v96, v101
    v_mul_f32 v97, v97, v101
    v_cvt_pk_bf16_f32 v90, v90, v90
    v_cvt_pk_bf16_f32 v91, v91, v91
    v_cvt_pk_bf16_f32 v92, v92, v92
    v_cvt_pk_bf16_f32 v93, v93, v93
    v_cvt_pk_bf16_f32 v94, v94, v94
    v_cvt_pk_bf16_f32 v95, v95, v95
    v_cvt_pk_bf16_f32 v96, v96, v96
    v_cvt_pk_bf16_f32 v97, v97, v97
    v_and_b32 v48, v90, v80
    v_and_b32 v49, v90, v81
    v_and_b32 v50, v90, v82
    v_and_b32 v51, v90, v83
    v_and_b32 v52, v91, v80
    v_and_b32 v53, v91, v81
    v_and_b32 v54, v91, v82
    v_and_b32 v55, v91, v83
    v_and_b32 v56, v92, v80
    v_and_b32 v57, v92, v81
    v_and_b32 v58, v92, v82
    v_and_b32 v59, v92, v83
    v_and_b32 v60, v93, v80
    v_and_b32 v61, v93, v81
    v_and_b32 v62, v93, v82
    v_and_b32 v63, v93, v83
    v_and_b32 v64, v94, v80
    v_and_b32 v65, v94, v81
    v_and_b32 v66, v94, v82
    v_and_b32 v67, v94, v83
    v_and_b32 v68, v95, v80
    v_and_b32 v69, v95, v81
    v_and_b32 v70, v95, v82
    v_and_b32 v71, v95, v83
    v_and_b32 v72, v96, v80
    v_and_b32 v73, v96, v81
    v_and_b32 v74, v96, v82
    v_and_b32 v75, v96, v83
    v_and_b32 v76, v97, v80
    v_and_b32 v77, v97, v81
    v_and_b32 v78, v97, v82
    v_and_b32 v79, v97, v83
    s_waitcnt vmcnt(7)
    v_mfma_f32_16x16x32_bf16 v[84:87], v[48:51], v[16:19], 0
    s_waitcnt vmcnt(6)
    v_mfma_f32_16x16x32_bf16 v[84:87], v[52:55], v[20:23], v[84:87]
    s_waitcnt vmcnt(5)
    v_mfma_f32_16x16x32_bf16 v[84:87], v[56:59], v[24:27], v[84:87]
    s_waitcnt vmcnt(4)
    v_mfma_f32_16x16x32_bf16 v[84:87], v[60:63], v[28:31], v[84:87]
    s_waitcnt vmcnt(3)
    v_mfma_f32_16x16x32_bf16 v[84:87], v[64:67], v[32:35], v[84:87]
    s_waitcnt vmcnt(2)
    v_mfma_f32_16x16x32_bf16 v[84:87], v[68:71], v[36:39], v[84:87]
    s_waitcnt vmcnt(1)
    v_mfma_f32_16x16x32_bf16 v[84:87], v[72:75], v[40:43], v[84:87]
    s_waitcnt vmcnt(0)
    v_mfma_f32_16x16x32_bf16 v[84:87], v[76:79], v[44:47], v[84:87]
    v_lshlrev_b32 v90, 5, v1
    v_and_b32 v91, 16, v0
    s_lshl_b32 s52, s27, 9
    v_add3_u32 v90, v90, v91, s52
    s_mov_b32 exec_lo, -1
    s_mov_b32 exec_hi, 0
    s_nop 1
    ds_write_b128 v90, v[84:87] offset:2048
    s_mov_b64 exec, -1
    s_lshl_b32 s52, s27, 2
    v_mov_b32 v91, s52
    v_mov_b32 v92, 1
    ds_write_b32 v91, v92 offset:0
    s_cmp_lg_u32 s27, 0
    s_cbranch_scc1 L_CD
    v_mov_b32 v89, 0
    s_mov_b32 s58, 1048576
L_lw_1:
    ds_read_b128 v[92:95], v89 offset:0
    s_waitcnt lgkmcnt(0)
    v_and_b32 v92, v92, v93
    v_and_b32 v94, v94, v95
    v_and_b32 v92, v92, v94
    v_cmp_ne_u32 vcc, 0, v92
    s_cbranch_vccnz L_lwd_2
    s_sub_u32 s58, s58, 1
    s_cbranch_scc1 L_lwd_2
    s_sleep 1
    s_branch L_lw_1
L_lwd_2:
    v_lshlrev_b32 v90, 3, v0
    ds_read_b64 v[92:93], v90 offset:2048
    ds_read_b64 v[94:95], v90 offset:2560
    ds_read_b64 v[96:97], v90 offset:3072
    ds_read_b64 v[98:99], v90 offset:3584
    v_add_u32 v90, s60, v3
    v_mov_b32 v101, v9
    v_mov_b32 v100, s96
    s_waitcnt lgkmcnt(0)
    v_pk_add_f32 v[92:93], v[92:93], v[94:95]
    v_pk_add_f32 v[96:97], v[96:97], v[98:99]
    v_pk_add_f32 v[98:99], v[92:93], v[96:97]
    buffer_store_dwordx4 v[98:101], v90, s[32:35], 0 offen
    ds_write_b128 v3, v[98:101] offset:8192
    v_mov_b32 v92, 1
    ds_write_b32 v89, v92 offset:64
    s_branch L_CD
L_A_none:
    v_mov_b32 v89, 0
    v_lshlrev_b32 v15, 2, v0
    ds_write_b32 v15, v89
    s_waitcnt lgkmcnt(0)
    s_barrier
    s_waitcnt vmcnt(0)
    v_add_u32 v9, 0x9e3779b1, v9
    v_or_b32 v9, 1, v9
    s_branch L_CD
L_B:
    s_setprio 2
    buffer_load_dword v9, off, s[32:35], 0 sc1
    s_lshl_b32 s52, s28, 21
    s_lshl_b32 s53, s29, 16
    s_add_u32 s52, s52, s53
    s_add_u32 s52, s52, 1572864
    s_add_u32 s44, s6, s52
    s_addc_u32 s45, s7, 0
    s_mov_b32 s46, 65536
    s_mov_b32 s47, 0x20000
    s_lshl_b32 s52, s27, 10
    v_add_u32 v4, s52, v3
    s_mul_i32 s52, s28, 5
    s_lshl_b32 s52, s52, 10
    s_lshl_b32 s53, s27, 8
    s_add_u32 s52, s52, s53
    s_add_u32 s52, s52, 4096
    v_lshlrev_b32 v100, 4, v1
    v_add_u32 v101, s52, v100
    v_lshlrev_b32 v100, 10, v2
    v_add_u32 v100, v101, v100
    v_add_u32 v101, 4096, v101
    v_lshrrev_b32 v102, 5, v0
    v_lshl_add_u32 v102, v1, 1, v102
    s_lshl_b32 s52, s27, 5
    v_add_u32 v102, s52, v102
    v_lshlrev_b32 v102, 1, v102
    v_lshlrev_b32 v103, 4, v1
    v_mov_b32 v5, 0
    s_barrier
    s_mov_b32 s52, s59
    buffer_load_dwordx4 v[16:19], v4, s[44:47], s52 offen nt
    s_add_u32 s52, s52, 4096
    s_and_b32 s52, s52, 0xffff
    buffer_load_dwordx4 v[20:23], v4, s[44:47], s52 offen nt
    s_add_u32 s52, s52, 4096
    s_and_b32 s52, s52, 0xffff
    buffer_load_dwordx4 v[24:27], v4, s[44:47], s52 offen nt
    s_add_u32 s52, s52, 4096
    s_and_b32 s52, s52, 0xffff
    buffer_load_dwordx4 v[28:31], v4, s[44:47], s52 offen nt
    s_add_u32 s52, s52, 4096
    s_and_b32 s52, s52, 0xffff
    buffer_load_dwordx4 v[32:35], v4, s[44:47], s52 offen nt
    s_add_u32 s52, s52, 4096
    s_and_b32 s52, s52, 0xffff
    buffer_load_dwordx4 v[36:39], v4, s[44:47], s52 offen nt
    s_add_u32 s52, s52, 4096
    s_and_b32 s52, s52, 0xffff
    buffer_load_dwordx4 v[40:43], v4, s[44:47], s52 offen nt
    s_add_u32 s52, s52, 4096
    s_and_b32 s52, s52, 0xffff
    buffer_load_dwordx4 v[44:47], v4, s[44:47], s52 offen nt
    s_add_u32 s52, s52, 4096
    s_and_b32 s52, s52, 0xffff
    s_waitcnt vmcnt(7)
    buffer_load_dwordx4 v[48:51], v4, s[44:47], s52 offen nt
    s_add_u32 s52, s52, 4096
    s_and_b32 s52, s52, 0xffff
    s_waitcnt vmcnt(7)
    buffer_load_dwordx4 v[52:55], v4, s[44:47], s52 offen nt
    s_add_u32 s52, s52, 4096
    s_and_b32 s52, s52, 0xffff
    s_waitcnt vmcnt(7)
    buffer_load_dwordx4 v[56:59], v4, s[44:47], s52 offen nt
    s_add_u32 s52, s52, 4096
    s_and_b32 s52, s52, 0xffff
    s_waitcnt vmcnt(7)
    buffer_load_dwordx4 v[60:63], v4, s[44:47], s52 offen nt
    s_add_u32 s52, s52, 4096
    s_and_b32 s52, s52, 0xffff
    s_waitcnt vmcnt(7)
    buffer_load_dwordx4 v[64:67], v4, s[44:47], s52 offen nt
    s_add_u32 s52, s52, 4096
    s_and_b32 s52, s52, 0xffff
    s_waitcnt vmcnt(7)
    buffer_load_dwordx4 v[68:71], v4, s[44:47], s52 offen nt
    s_add_u32 s52, s52, 4096
    s_and_b32 s52, s52, 0xffff
    s_waitcnt vmcnt(7)
    buffer_load_dwordx4 v[72:75], v4, s[44:47], s52 offen nt
    s_add_u32 s52, s52, 4096
    s_and_b32 s52, s52, 0xffff
    s_waitcnt vmcnt(7)
    buffer_load_dwordx4 v[76:79], v4, s[44:47], s52 offen nt
    s_mov_b32 s58, 0
    buffer_load_dwordx4 v[92:95], v100, s[32:35], 0 offen sc1
    buffer_load_dwordx4 v[96:99], v101, s[32:35], 0 offen sc1
    s_lshl_b32 s52, s27, 2
    v_mov_b32 v6, s52
    v_mov_b32 v7, 1
    ds_write_b32 v6, v7 offset:48
    s_waitcnt vmcnt(18)
    v_add_u32 v9, 0x9e3779b1, v9
    v_or_b32 v9, 1, v9
    s_branch L_B_pl_w
L_B_pl:
    buffer_load_dwordx4 v[92:95], v100, s[32:35], 0 offen sc1
    buffer_load_dwordx4 v[96:99], v101, s[32:35], 0 offen sc1
L_B_pl_w:
    s_waitcnt vmcnt(0)
    v_cmp_ne_u32 vcc, v95, v9
    v_cmp_ne_u32 s[52:53], v99, v9
    s_or_b64 vcc, vcc, s[52:53]
    s_cbranch_vccz L_B_pd
    s_add_u32 s58, s58, 1
    s_cmp_lt_u32 s58, 6
    s_cbranch_scc1 L_B_pl
    s_cmp_lt_u32 s29, 5
    s_cbranch_scc0 L_bf_3
    s_mul_i32 s55, s28, 5
    s_add_u32 s55, s55, s29
    s_lshl_b32 s55, s55, 10
    s_add_u32 s55, s55, 4096
    v_mov_b32 v116, 0
    s_mov_b32 s54, 1048576
L_wb_4:
    ds_read_b32 v112, v116 offset:64
    s_waitcnt lgkmcnt(0)
    v_cmp_ne_u32 vcc, 0, v112
    s_cbranch_vccnz L_wbd_5
    s_sub_u32 s54, s54, 1
    s_cbranch_scc1 L_wbd_5
    s_sleep 1
    s_branch L_wb_4
L_wbd_5:
    ds_read_b128 v[112:115], v3 offset:8192
    v_add_u32 v116, s55, v3
    s_mov_b32 s54, 1048576
    s_waitcnt lgkmcnt(0)
    buffer_store_dwordx4 v[112:115], v116, s[32:35], s54 offen sc1
L_bf_3:
    s_mov_b32 s61, 1048576
L_B_pl_fb:
    buffer_load_dwordx4 v[104:107], v100, s[32:35], s61 offen sc1
    buffer_load_dwordx4 v[108:111], v101, s[32:35], s61 offen sc1
    s_waitcnt vmcnt(0)
    v_cmp_eq_u32 vcc, v107, v9
    s_nop 1
    v_cndmask_b32 v92, v92, v104, vcc
    v_cndmask_b32 v93, v93, v105, vcc
    v_cndmask_b32 v94, v94, v106, vcc
    v_cndmask_b32 v95, v95, v107, vcc
    v_cmp_eq_u32 vcc, v111, v9
    s_nop 1
    v_cndmask_b32 v96, v96, v108, vcc
    v_cndmask_b32 v97, v97, v109, vcc
    v_cndmask_b32 v98, v98, v110, vcc
    v_cndmask_b32 v99, v99, v111, vcc
    v_cmp_ne_u32 vcc, v95, v9
    v_cmp_ne_u32 s[52:53], v99, v9
    s_or_b64 vcc, vcc, s[52:53]
    s_cbranch_vccz L_B_pd
    s_xor_b32 s61, s61, 1048576
    s_add_u32 s58, s58, 1
    s_cmp_lt_u32 s58, 65536
    s_cbranch_scc1 L_B_pl_fb
L_B_pd:
    v_cmp_gt_u32 vcc, 32, v0
    v_permlane32_swap_b32 v92, v93
    s_nop 0
    v_cndmask_b32 v96, v97, v96, vcc
    v_add_f32 v92, v92, v93
    v_mov_b32 v93, v92
    s_nop 1
    v_permlane16_swap_b32 v92, v93
    v_add_f32 v92, v92, v93
    v_add_f32 v92, v92, v96
    v_cvt_pk_bf16_f32 v92, v92, v92
    ds_write_b16 v102, v92 offset:128
    s_lshl_b32 s52, s27, 2
    v_mov_b32 v104, s52
    v_mov_b32 v105, 1
    ds_write_b32 v104, v105 offset:16
    v_cmp_ne_u32 vcc, s96, v94
    v_cmp_ne_u32 s[52:53], s96, v98
    s_or_b64 vcc, vcc, s[52:53]
    s_cmp_lg_u64 vcc, 0
    s_cselect_b32 s53, 1, 0
    s_lshl_b32 s52, s27, 2
    v_mov_b32 v6, s52
    v_mov_b32 v7, s53
    ds_write_b32 v6, v7 offset:416
    s_mov_b32 s58, 1048576
L_lw_6:
    ds_read_b128 v[84:87], v5 offset:16
    s_waitcnt lgkmcnt(0)
    v_and_b32 v84, v84, v85
    v_and_b32 v86, v86, v87
    v_and_b32 v84, v84, v86
    v_cmp_ne_u32 vcc, 0, v84
    s_cbranch_vccnz L_lwd_7
    s_sub_u32 s58, s58, 1
    s_cbranch_scc1 L_lwd_7
    s_sleep 1
    s_branch L_lw_6
L_lwd_7:
    ds_read_b128 v[80:83], v103 offset:128
    s_waitcnt lgkmcnt(0)
    v_dot2_f32_bf16 v84, v16, v80, 0
    v_dot2_f32_bf16 v84, v17, v81, v84
    v_dot2_f32_bf16 v84, v18, v82, v84
    v_dot2_f32_bf16 v84, v19, v83, v84
    v_dot2_f32_bf16 v85, v20, v80, 0
    v_dot2_f32_bf16 v85, v21, v81, v85
    v_dot2_f32_bf16 v85, v22, v82, v85
    v_dot2_f32_bf16 v85, v23, v83, v85
    v_dot2_f32_bf16 v86, v24, v80, 0
    v_dot2_f32_bf16 v86, v25, v81, v86
    v_dot2_f32_bf16 v86, v26, v82, v86
    v_dot2_f32_bf16 v86, v27, v83, v86
    v_dot2_f32_bf16 v87, v28, v80, 0
    v_dot2_f32_bf16 v87, v29, v81, v87
    v_dot2_f32_bf16 v87, v30, v82, v87
    v_dot2_f32_bf16 v87, v31, v83, v87
    v_dot2_f32_bf16 v88, v32, v80, 0
    v_dot2_f32_bf16 v88, v33, v81, v88
    v_dot2_f32_bf16 v88, v34, v82, v88
    v_dot2_f32_bf16 v88, v35, v83, v88
    v_dot2_f32_bf16 v89, v36, v80, 0
    v_dot2_f32_bf16 v89, v37, v81, v89
    v_dot2_f32_bf16 v89, v38, v82, v89
    v_dot2_f32_bf16 v89, v39, v83, v89
    v_dot2_f32_bf16 v90, v40, v80, 0
    v_dot2_f32_bf16 v90, v41, v81, v90
    v_dot2_f32_bf16 v90, v42, v82, v90
    v_dot2_f32_bf16 v90, v43, v83, v90
    v_dot2_f32_bf16 v91, v44, v80, 0
    v_dot2_f32_bf16 v91, v45, v81, v91
    v_dot2_f32_bf16 v91, v46, v82, v91
    v_dot2_f32_bf16 v91, v47, v83, v91
    v_dot2_f32_bf16 v92, v48, v80, 0
    v_dot2_f32_bf16 v92, v49, v81, v92
    v_dot2_f32_bf16 v92, v50, v82, v92
    v_dot2_f32_bf16 v92, v51, v83, v92
    v_dot2_f32_bf16 v93, v52, v80, 0
    v_dot2_f32_bf16 v93, v53, v81, v93
    v_dot2_f32_bf16 v93, v54, v82, v93
    v_dot2_f32_bf16 v93, v55, v83, v93
    v_dot2_f32_bf16 v94, v56, v80, 0
    v_dot2_f32_bf16 v94, v57, v81, v94
    v_dot2_f32_bf16 v94, v58, v82, v94
    v_dot2_f32_bf16 v94, v59, v83, v94
    v_dot2_f32_bf16 v95, v60, v80, 0
    v_dot2_f32_bf16 v95, v61, v81, v95
    v_dot2_f32_bf16 v95, v62, v82, v95
    v_dot2_f32_bf16 v95, v63, v83, v95
    v_dot2_f32_bf16 v96, v64, v80, 0
    v_dot2_f32_bf16 v96, v65, v81, v96
    v_dot2_f32_bf16 v96, v66, v82, v96
    v_dot2_f32_bf16 v96, v67, v83, v96
    v_dot2_f32_bf16 v97, v68, v80, 0
    v_dot2_f32_bf16 v97, v69, v81, v97
    v_dot2_f32_bf16 v97, v70, v82, v97
    v_dot2_f32_bf16 v97, v71, v83, v97
    v_dot2_f32_bf16 v98, v72, v80, 0
    v_dot2_f32_bf16 v98, v73, v81, v98
    v_dot2_f32_bf16 v98, v74, v82, v98
    v_dot2_f32_bf16 v98, v75, v83, v98
    v_dot2_f32_bf16 v99, v76, v80, 0
    v_dot2_f32_bf16 v99, v77, v81, v99
    v_dot2_f32_bf16 v99, v78, v82, v99
    v_dot2_f32_bf16 v99, v79, v83, v99
    v_add_f32_dpp v84, v84, v84 row_ror:8 row_mask:0xf bank_mask:0x3
    v_add_f32_dpp v84, v92, v92 row_ror:8 row_mask:0xf bank_mask:0xc
    v_add_f32_dpp v85, v85, v85 row_ror:8 row_mask:0xf bank_mask:0x3
    v_add_f32_dpp v85, v93, v93 row_ror:8 row_mask:0xf bank_mask:0xc
    v_add_f32_dpp v86, v86, v86 row_ror:8 row_mask:0xf bank_mask:0x3
    v_add_f32_dpp v86, v94, v94 row_ror:8 row_mask:0xf bank_mask:0xc
    v_add_f32_dpp v87, v87, v87 row_ror:8 row_mask:0xf bank_mask:0x3
    v_add_f32_dpp v87, v95, v95 row_ror:8 row_mask:0xf bank_mask:0xc
    v_add_f32_dpp v88, v88, v88 row_ror:8 row_mask:0xf bank_mask:0x3
    v_add_f32_dpp v88, v96, v96 row_ror:8 row_mask:0xf bank_mask:0xc
    v_add_f32_dpp v89, v89, v89 row_ror:8 row_mask:0xf bank_mask:0x3
    v_add_f32_dpp v89, v97, v97 row_ror:8 row_mask:0xf bank_mask:0xc
    v_add_f32_dpp v90, v90, v90 row_ror:8 row_mask:0xf bank_mask:0x3
    v_add_f32_dpp v90, v98, v98 row_ror:8 row_mask:0xf bank_mask:0xc
    v_add_f32_dpp v91, v91, v91 row_ror:8 row_mask:0xf bank_mask:0x3
    v_add_f32_dpp v91, v99, v99 row_ror:8 row_mask:0xf bank_mask:0xc
    v_add_f32_dpp v84, v84, v84 row_half_mirror row_mask:0xf bank_mask:0x5
    v_add_f32_dpp v84, v88, v88 row_half_mirror row_mask:0xf bank_mask:0xa
    v_add_f32_dpp v85, v85, v85 row_half_mirror row_mask:0xf bank_mask:0x5
    v_add_f32_dpp v85, v89, v89 row_half_mirror row_mask:0xf bank_mask:0xa
    v_add_f32_dpp v86, v86, v86 row_half_mirror row_mask:0xf bank_mask:0x5
    v_add_f32_dpp v86, v90, v90 row_half_mirror row_mask:0xf bank_mask:0xa
    v_add_f32_dpp v87, v87, v87 row_half_mirror row_mask:0xf bank_mask:0x5
    v_add_f32_dpp v87, v91, v91 row_half_mirror row_mask:0xf bank_mask:0xa
    v_add_f32_dpp v88, v84, v84 quad_perm:[2,3,0,1] row_mask:0xf bank_mask:0xf
    v_add_f32_dpp v89, v85, v85 quad_perm:[2,3,0,1] row_mask:0xf bank_mask:0xf
    v_add_f32_dpp v90, v86, v86 quad_perm:[2,3,0,1] row_mask:0xf bank_mask:0xf
    v_add_f32_dpp v91, v87, v87 quad_perm:[2,3,0,1] row_mask:0xf bank_mask:0xf
    v_and_b32 v6, 2, v0
    v_cmp_eq_u32 vcc, 0, v6
    s_nop 1
    v_cndmask_b32 v84, v90, v88, vcc
    v_cndmask_b32 v85, v91, v89, vcc
    v_and_b32 v6, 1, v0
    v_add_f32_dpp v88, v84, v84 quad_perm:[1,0,3,2] row_mask:0xf bank_mask:0xf
    v_add_f32_dpp v89, v85, v85 quad_perm:[1,0,3,2] row_mask:0xf bank_mask:0xf
    v_cmp_eq_u32 vcc, 0, v6
    s_nop 1
    v_cndmask_b32 v84, v89, v88, vcc
    v_cvt_pk_bf16_f32 v84, v84, v84
    v_and_b32 v84, 0xffff0000, v84
    v_mul_f32 v84, 0x3db504f3, v84
    v_cvt_pk_bf16_f32 v84, v84, v84
    v_and_b32 v84, 0xffff0000, v84
    v_mov_b32 v85, v84
    s_nop 1
    v_max_f32_dpp v85, v85, v85 row_ror:8 row_mask:0xf bank_mask:0xf
    s_nop 1
    v_max_f32_dpp v85, v85, v85 row_ror:4 row_mask:0xf bank_mask:0xf
    s_nop 1
    v_max_f32_dpp v85, v85, v85 row_ror:2 row_mask:0xf bank_mask:0xf
    s_nop 1
    v_max_f32_dpp v85, v85, v85 row_ror:1 row_mask:0xf bank_mask:0xf
    v_mov_b32 v86, v85
    s_nop 1
    v_permlane16_swap_b32 v85, v86
    v_max_f32 v85, v85, v86
    v_mov_b32 v86, v85
    s_nop 1
    v_permlane32_swap_b32 v85, v86
    v_max_f32 v85, v85, v86
    v_sub_f32 v86, v84, v85
    v_mul_f32 v86, 0x3fb8aa3b, v86
    v_exp_f32 v86, v86
    s_lshl_b32 s52, s27, 8
    v_lshlrev_b32 v6, 2, v0
    v_add_u32 v6, s52, v6
    v_cvt_pk_bf16_f32 v87, v86, v86
    ds_write_b32 v6, v87 offset:512
    v_add_f32_dpp v86, v86, v86 row_ror:8 row_mask:0xf bank_mask:0xf
    s_nop 1
    v_add_f32_dpp v86, v86, v86 row_ror:4 row_mask:0xf bank_mask:0xf
    s_nop 1
    v_add_f32_dpp v86, v86, v86 row_ror:2 row_mask:0xf bank_mask:0xf
    s_nop 1
    v_add_f32_dpp v86, v86, v86 row_ror:1 row_mask:0xf bank_mask:0xf
    v_mov_b32 v88, v86
    s_nop 1
    v_permlane16_swap_b32 v86, v88
    v_add_f32 v86, v86, v88
    v_mov_b32 v88, v86
    s_nop 1
    v_permlane32_swap_b32 v86, v88
    v_add_f32 v86, v86, v88
    v_mov_b32 v88, v85
    v_mov_b32 v89, v86
    s_lshl_b32 s52, s27, 3
    v_mov_b32 v6, s52
    ds_write_b64 v6, v[88:89] offset:384
    s_lshl_b32 s52, s27, 2
    v_mov_b32 v6, s52
    v_mov_b32 v7, 1
    ds_write_b32 v6, v7 offset:32
    s_endpgm
L_CD:
    s_setprio 0
    s_mov_b32 s36, s4
    s_mov_b32 s37, s5
    s_mov_b32 s38, 1280
    s_mov_b32 s39, 0x20000
    s_lshl_b32 s52, s2, 3
    v_and_b32 v7, 1, v0
    v_lshlrev_b32 v7, 2, v7
    v_add_u32 v10, s52, v7
    buffer_load_dword v8, v10, s[36:39], 0 offen
    s_lshl_b32 s52, s28, 21
    s_lshl_b32 s53, s29, 16
    s_add_u32 s52, s52, s53
    s_add_u32 s52, s52, 1572864
    s_add_u32 s44, s8, s52
    s_addc_u32 s45, s9, 0
    s_mov_b32 s46, 65536
    s_mov_b32 s47, 0x20000
    s_lshl_b32 s52, s27, 10
    v_add_u32 v4, s52, v3
    s_cmp_lt_u32 s29, 5
    s_cbranch_scc0 L_C_ffn
    s_mul_i32 s52, s28, 163840
    s_lshl_b32 s53, s29, 8
    s_add_u32 s52, s52, s53
    s_add_u32 s40, s12, s52
    s_addc_u32 s41, s13, 0
    s_sub_u32 s42, 5242880, s52
    s_mov_b32 s43, 0x20000
    s_mul_i32 s52, s27, 40960
    v_mul_u32_u24 v5, 10240, v2
    v_lshlrev_b32 v6, 4, v1
    v_add3_u32 v5, v5, v6, s52
    v_add_u32 v6, 5120, v5
    v_and_b32 v12, 7, v0
    v_lshlrev_b32 v12, 10, v12
    v_lshrrev_b32 v13, 3, v0
    v_lshlrev_b32 v13, 4, v13
    s_lshl_b32 s52, s28, 13
    s_lshl_b32 s53, s27, 7
    s_add_u32 s52, s52, s53
    s_add_u32 s52, s52, 327680
    v_add3_u32 v163, v12, v13, s52
    s_lshl_b32 s60, s29, 5
    s_add_u32 s60, s60, s28
    s_lshl_b32 s60, s60, 10
    s_add_u32 s60, s60, 589824
    s_mov_b32 s62, 1
    v_mov_b32 v170, 0
    s_branch L_C_go
L_C_ffn:
    s_min_u32 s54, s63, 13
    s_mul_i32 s52, s54, 163840
    s_lshl_b32 s53, s30, 8
    s_add_u32 s52, s52, s53
    s_add_u32 s40, s18, s52
    s_addc_u32 s41, s19, 0
    s_sub_u32 s42, 2211840, s52
    s_mov_b32 s43, 0x20000
    s_mul_i32 s52, s27, 40960
    v_mul_u32_u24 v5, 10240, v2
    v_lshlrev_b32 v6, 4, v1
    v_add3_u32 v5, v5, v6, s52
    v_add_u32 v6, 5120, v5
    v_and_b32 v12, 3, v0
    v_lshl_add_u32 v12, v2, 2, v12
    v_lshlrev_b32 v12, 4, v12
    s_mul_i32 s52, s54, 5120
    s_lshl_b32 s53, s27, 8
    s_add_u32 s52, s52, s53
    s_add_u32 s52, s52, 196608
    v_add_u32 v12, s52, v12
    v_add_u32 v170, 4096, v12
    v_bfe_u32 v13, v0, 2, 2
    v_lshlrev_b32 v13, 10, v13
    v_add_u32 v163, v12, v13
    s_lshl_b32 s60, s30, 5
    s_add_u32 s60, s60, s63
    s_lshl_b32 s60, s60, 10
    s_add_u32 s60, s60, 786432
    s_mov_b32 s62, 1
    s_cmp_ge_u32 s63, 14
    s_cbranch_scc0 L_C_go
    v_mov_b32 v5, 0x7ff00000
    v_mov_b32 v6, 0x7ff00000
    s_mov_b32 s62, 0
L_C_go:
    v_lshlrev_b32 v12, 5, v1
    v_and_b32 v13, 16, v0
    v_add_u32 v12, v12, v13
    s_lshl_b32 s52, s27, 9
    v_add_u32 v160, s52, v12
    s_lshl_b32 s52, s27, 9
    v_add_u32 v164, s52, v12
    v_and_b32 v12, 31, v0
    v_lshlrev_b32 v161, 4, v12
    s_lshl_b32 s52, s28, 3
    s_add_u32 s52, s52, s29
    s_lshl_b32 s52, s52, 10
    s_add_u32 s52, s52, 327680
    v_add_u32 v162, s52, v3
    v_lshlrev_b32 v165, 3, v0
    v_add_u32 v166, s60, v3
    s_lshr_b32 s52, s2, 5
    s_and_b32 s53, s2, 31
    s_lshl_b32 s52, s52, 15
    s_lshl_b32 s53, s53, 5
    s_add_u32 s52, s52, s53
    v_lshrrev_b32 v169, 1, v0
    v_and_b32 v13, 1, v0
    v_lshlrev_b32 v13, 4, v13
    v_add_u32 v13, s52, v13
    v_min_u32 v14, 13, v169
    v_lshlrev_b32 v14, 10, v14
    v_lshlrev_b32 v15, 10, v169
    v_add_u32 v14, v14, v13
    v_add_u32 v15, v15, v13
    v_add_u32 v168, 0xc0000, v14
    v_add_u32 v167, 0x90000, v15
    s_mov_b32 s48, s20
    s_mov_b32 s49, s21
    s_mov_b32 s50, 1280
    s_mov_b32 s51, 0x20000
    v_and_b32 v148, 1, v0
    v_mov_b32 v149, 0xffff
    v_lshlrev_b32 v148, 4, v148
    v_lshlrev_b32 v149, v148, v149
    v_and_b32 v148, 8, v0
    v_cmp_eq_u32 vcc, 0, v148
    s_nop 1
    v_cndmask_b32 v149, 0, v149, vcc
    v_bfe_u32 v148, v0, 1, 2
    v_cmp_eq_u32 vcc, 0, v148
    s_nop 1
    v_cndmask_b32 v128, 0, v149, vcc
    v_cmp_eq_u32 vcc, 1, v148
    s_nop 1
    v_cndmask_b32 v129, 0, v149, vcc
    v_cmp_eq_u32 vcc, 2, v148
    s_nop 1
    v_cndmask_b32 v130, 0, v149, vcc
    v_cmp_eq_u32 vcc, 3, v148
    s_nop 1
    v_cndmask_b32 v131, 0, v149, vcc
    s_lshl_b32 s52, s27, 2
    v_mov_b32 v11, s52
    s_mov_b32 s58, 1048576
L_gw:
    ds_read_b32 v12, v11 offset:48
    s_waitcnt lgkmcnt(0)
    v_cmp_ne_u32 vcc, 0, v12
    s_cbranch_vccnz L_gd
    s_sub_u32 s58, s58, 1
    s_cbranch_scc1 L_gd
    s_sleep 1
    s_branch L_gw
L_gd:
    v_mov_b32 v11, 0
    s_mov_b32 s52, s59
    buffer_load_dwordx4 v[16:19], v4, s[44:47], s52 offen nt
    s_add_u32 s52, s52, 4096
    s_and_b32 s52, s52, 0xffff
    buffer_load_dwordx4 v[20:23], v4, s[44:47], s52 offen nt
    s_add_u32 s52, s52, 4096
    s_and_b32 s52, s52, 0xffff
    buffer_load_dwordx4 v[24:27], v4, s[44:47], s52 offen nt
    s_add_u32 s52, s52, 4096
    s_and_b32 s52, s52, 0xffff
    buffer_load_dwordx4 v[28:31], v4, s[44:47], s52 offen nt
    s_add_u32 s52, s52, 4096
    s_and_b32 s52, s52, 0xffff
    buffer_load_dwordx4 v[32:35], v4, s[44:47], s52 offen nt
    s_add_u32 s52, s52, 4096
    s_and_b32 s52, s52, 0xffff
    buffer_load_dwordx4 v[36:39], v4, s[44:47], s52 offen nt
    s_add_u32 s52, s52, 4096
    s_and_b32 s52, s52, 0xffff
    buffer_load_dwordx4 v[40:43], v4, s[44:47], s52 offen nt
    s_add_u32 s52, s52, 4096
    s_and_b32 s52, s52, 0xffff
    buffer_load_dwordx4 v[44:47], v4, s[44:47], s52 offen nt
    s_add_u32 s52, s52, 4096
    s_and_b32 s52, s52, 0xffff
    s_cmp_lt_u32 s29, 5
    s_cbranch_scc1 L_fe_8
    s_cmp_eq_u32 s62, 0
    s_cbranch_scc1 L_fe_8
    buffer_load_dwordx4 v[148:151], v163, s[32:35], 0 offen sc1
    buffer_load_dwordx4 v[152:155], v170, s[32:35], 0 offen sc1
L_fe_8:
    s_waitcnt vmcnt(7)
    buffer_load_dwordx4 v[48:51], v4, s[44:47], s52 offen nt
    s_add_u32 s52, s52, 4096
    s_and_b32 s52, s52, 0xffff
    s_waitcnt vmcnt(7)
    buffer_load_dwordx4 v[52:55], v4, s[44:47], s52 offen nt
    s_add_u32 s52, s52, 4096
    s_and_b32 s52, s52, 0xffff
    s_waitcnt vmcnt(7)
    buffer_load_dwordx4 v[56:59], v4, s[44:47], s52 offen nt
    s_add_u32 s52, s52, 4096
    s_and_b32 s52, s52, 0xffff
    s_waitcnt vmcnt(7)
    buffer_load_dwordx4 v[60:63], v4, s[44:47], s52 offen nt
    s_add_u32 s52, s52, 4096
    s_and_b32 s52, s52, 0xffff
    s_waitcnt vmcnt(7)
    buffer_load_dwordx4 v[64:67], v4, s[44:47], s52 offen nt
    s_add_u32 s52, s52, 4096
    s_and_b32 s52, s52, 0xffff
    s_waitcnt vmcnt(7)
    buffer_load_dwordx4 v[68:71], v4, s[44:47], s52 offen nt
    s_add_u32 s52, s52, 4096
    s_and_b32 s52, s52, 0xffff
    s_waitcnt vmcnt(7)
    buffer_load_dwordx4 v[72:75], v4, s[44:47], s52 offen nt
    s_add_u32 s52, s52, 4096
    s_and_b32 s52, s52, 0xffff
    s_waitcnt vmcnt(7)
    buffer_load_dwordx4 v[76:79], v4, s[44:47], s52 offen nt
    s_cmp_lt_u32 s29, 5
    s_cbranch_scc1 L_fs_9
    s_cmp_eq_u32 s62, 0
    s_cbranch_scc1 L_fs_9
    s_waitcnt vmcnt(8)
    v_cmp_ne_u32 vcc, v151, v9
    v_cmp_ne_u32 s[52:53], v155, v9
    s_or_b64 vcc, vcc, s[52:53]
    s_cbranch_vccz L_fe_ok
    s_mov_b32 s58, 0
L_FE_pl:
    buffer_load_dwordx4 v[148:151], v163, s[32:35], 0 offen sc1
    buffer_load_dwordx4 v[152:155], v170, s[32:35], 0 offen sc1
L_FE_pl_w:
    s_waitcnt vmcnt(0)
    v_cmp_ne_u32 vcc, v151, v9
    v_cmp_ne_u32 s[52:53], v155, v9
    s_or_b64 vcc, vcc, s[52:53]
    s_cbranch_vccz L_FE_pd
    s_add_u32 s58, s58, 1
    s_cmp_lt_u32 s58, 4
    s_cbranch_scc1 L_FE_pl
    v_mov_b32 v124, 0
    s_mov_b32 s54, 1048576
L_wb_10:
    ds_read_b32 v120, v124 offset:64
    s_waitcnt lgkmcnt(0)
    v_cmp_ne_u32 vcc, 0, v120
    s_cbranch_vccnz L_wbd_11
    s_sub_u32 s54, s54, 1
    s_cbranch_scc1 L_wbd_11
    s_sleep 1
    s_branch L_wb_10
L_wbd_11:
    ds_read_b128 v[120:123], v3 offset:8192
    v_add_u32 v124, s97, v3
    s_mov_b32 s54, 1048576
    s_waitcnt lgkmcnt(0)
    buffer_store_dwordx4 v[120:123], v124, s[32:35], s54 offen sc1
    s_mov_b32 s61, 1048576
L_FE_pl_fb:
    buffer_load_dwordx4 v[112:115], v163, s[32:35], s61 offen sc1
    buffer_load_dwordx4 v[116:119], v170, s[32:35], s61 offen sc1
    s_waitcnt vmcnt(0)
    v_cmp_eq_u32 vcc, v115, v9
    s_nop 1
    v_cndmask_b32 v148, v148, v112, vcc
    v_cndmask_b32 v149, v149, v113, vcc
    v_cndmask_b32 v150, v150, v114, vcc
    v_cndmask_b32 v151, v151, v115, vcc
    v_cmp_eq_u32 vcc, v119, v9
    s_nop 1
    v_cndmask_b32 v152, v152, v116, vcc
    v_cndmask_b32 v153, v153, v117, vcc
    v_cndmask_b32 v154, v154, v118, vcc
    v_cndmask_b32 v155, v155, v119, vcc
    v_cmp_ne_u32 vcc, v151, v9
    v_cmp_ne_u32 s[52:53], v155, v9
    s_or_b64 vcc, vcc, s[52:53]
    s_cbranch_vccz L_FE_pd
    s_xor_b32 s61, s61, 1048576
    s_add_u32 s58, s58, 1
    s_cmp_lt_u32 s58, 65536
    s_cbranch_scc1 L_FE_pl_fb
L_FE_pd:
L_fe_ok:
    v_cmp_ne_u32 vcc, s96, v150
    v_cmp_ne_u32 s[52:53], s96, v154
    s_or_b64 vcc, vcc, s[52:53]
    s_cmp_lg_u64 vcc, 0
    s_cselect_b32 s56, 1, 0
    v_add_f32_dpp v148, v148, v148 row_ror:4 row_mask:0xf bank_mask:0xf
    v_add_f32_dpp v149, v149, v149 row_ror:4 row_mask:0xf bank_mask:0xf
    s_nop 0
    v_add_f32_dpp v148, v148, v148 row_ror:8 row_mask:0xf bank_mask:0xf
    v_add_f32_dpp v149, v149, v149 row_ror:8 row_mask:0xf bank_mask:0xf
    v_pk_add_f32 v[148:149], v[148:149], v[152:153]
    v_cvt_pk_bf16_f32 v148, v148, v149
    v_and_b32 v149, 0xffff0000, v148
    v_lshlrev_b32 v148, 16, v148
    v_mul_f32 v152, 0xbfb8aa3b, v148
    v_mul_f32 v153, 0xbfb8aa3b, v149
    v_exp_f32 v152, v152
    v_exp_f32 v153, v153
    v_add_f32 v152, 1.0, v152
    v_add_f32 v153, 1.0, v153
    v_rcp_f32 v152, v152
    v_rcp_f32 v153, v153
    v_mul_f32 v148, v148, v152
    v_mul_f32 v149, v149, v153
    v_cvt_pk_bf16_f32 v176, v148, v148
    v_cvt_pk_bf16_f32 v177, v149, v149
L_fs_9:
    ds_read_b128 v[148:151], v11 offset:32
    s_waitcnt lgkmcnt(0)
    v_and_b32 v148, v148, v149
    v_and_b32 v150, v150, v151
    v_and_b32 v148, v148, v150
    v_cmp_ne_u32 vcc, 0, v148
    s_cbranch_vccz L_C_late
    s_lshl_b32 s52, s27, 8
    v_lshlrev_b32 v12, 6, v2
    v_add_u32 v12, s52, v12
    ds_read_b128 v[112:115], v12 offset:512
    ds_read_b128 v[116:119], v12 offset:528
    ds_read_b128 v[120:123], v12 offset:544
    ds_read_b128 v[124:127], v12 offset:560
    ds_read_b128 v[148:151], v11 offset:384
    ds_read_b128 v[152:155], v11 offset:400
    ds_read_b32 v159, v11 offset:416
    s_waitcnt lgkmcnt(0)
    v_readfirstlane_b32 s57, v159
    v_max_f32 v156, v148, v150
    v_max_f32 v157, v152, v154
    v_max_f32 v156, v156, v157
    v_sub_f32 v148, v148, v156
    v_sub_f32 v150, v150, v156
    v_sub_f32 v152, v152, v156
    v_sub_f32 v154, v154, v156
    v_mul_f32 v148, 0x3fb8aa3b, v148
    v_mul_f32 v150, 0x3fb8aa3b, v150
    v_mul_f32 v152, 0x3fb8aa3b, v152
    v_mul_f32 v154, 0x3fb8aa3b, v154
    v_exp_f32 v148, v148
    v_exp_f32 v150, v150
    v_exp_f32 v152, v152
    v_exp_f32 v154, v154
    v_mul_f32 v157, v148, v149
    v_fmac_f32 v157, v150, v151
    v_fmac_f32 v157, v152, v153
    v_fmac_f32 v157, v154, v155
    v_mov_b32 v158, v148
    s_cmp_eq_u32 s27, 1
    s_cselect_b64 vcc, -1, 0
    v_cndmask_b32 v158, v158, v150, vcc
    s_cmp_eq_u32 s27, 2
    s_cselect_b64 vcc, -1, 0
    v_cndmask_b32 v158, v158, v152, vcc
    s_cmp_eq_u32 s27, 3
    s_cselect_b64 vcc, -1, 0
    v_cndmask_b32 v158, v158, v154, vcc
    s_waitcnt vmcnt(7)
    buffer_load_dwordx4 v[80:83], v5, s[40:43], 0 offen offset:0 nt
    v_and_b32 v132, v112, v128
    v_and_b32 v133, v112, v129
    v_and_b32 v134, v112, v130
    v_and_b32 v135, v112, v131
    v_and_b32 v136, v113, v128
    v_and_b32 v137, v113, v129
    v_and_b32 v138, v113, v130
    v_and_b32 v139, v113, v131
    s_waitcnt vmcnt(16)
    v_mfma_f32_16x16x32_bf16 v[140:143], v[132:135], v[16:19], 0
    s_waitcnt vmcnt(15)
    v_mfma_f32_16x16x32_bf16 v[140:143], v[136:139], v[20:23], v[140:143]
    s_waitcnt vmcnt(7)
    buffer_load_dwordx4 v[84:87], v5, s[40:43], 0 offen offset:1280 nt
    v_and_b32 v132, v114, v128
    v_and_b32 v133, v114, v129
    v_and_b32 v134, v114, v130
    v_and_b32 v135, v114, v131
    v_and_b32 v136, v115, v128
    v_and_b32 v137, v115, v129
    v_and_b32 v138, v115, v130
    v_and_b32 v139, v115, v131
    s_waitcnt vmcnt(15)
    v_mfma_f32_16x16x32_bf16 v[140:143], v[132:135], v[24:27], v[140:143]
    s_waitcnt vmcnt(14)
    v_mfma_f32_16x16x32_bf16 v[140:143], v[136:139], v[28:31], v[140:143]
    s_waitcnt vmcnt(7)
    buffer_load_dwordx4 v[88:91], v5, s[40:43], 0 offen offset:2560 nt
    v_and_b32 v132, v116, v128
    v_and_b32 v133, v116, v129
    v_and_b32 v134, v116, v130
    v_and_b32 v135, v116, v131
    v_and_b32 v136, v117, v128
    v_and_b32 v137, v117, v129
    v_and_b32 v138, v117, v130
    v_and_b32 v139, v117, v131
    s_waitcnt vmcnt(14)
    v_mfma_f32_16x16x32_bf16 v[140:143], v[132:135], v[32:35], v[140:143]
    s_waitcnt vmcnt(13)
    v_mfma_f32_16x16x32_bf16 v[140:143], v[136:139], v[36:39], v[140:143]
    s_waitcnt vmcnt(7)
    buffer_load_dwordx4 v[92:95], v5, s[40:43], 0 offen offset:3840 nt
    v_and_b32 v132, v118, v128
    v_and_b32 v133, v118, v129
    v_and_b32 v134, v118, v130
    v_and_b32 v135, v118, v131
    v_and_b32 v136, v119, v128
    v_and_b32 v137, v119, v129
    v_and_b32 v138, v119, v130
    v_and_b32 v139, v119, v131
    s_waitcnt vmcnt(13)
    v_mfma_f32_16x16x32_bf16 v[140:143], v[132:135], v[40:43], v[140:143]
    s_waitcnt vmcnt(12)
    v_mfma_f32_16x16x32_bf16 v[140:143], v[136:139], v[44:47], v[140:143]
    s_waitcnt vmcnt(7)
    buffer_load_dwordx4 v[96:99], v6, s[40:43], 0 offen offset:0 nt
    v_and_b32 v132, v120, v128
    v_and_b32 v133, v120, v129
    v_and_b32 v134, v120, v130
    v_and_b32 v135, v120, v131
    v_and_b32 v136, v121, v128
    v_and_b32 v137, v121, v129
    v_and_b32 v138, v121, v130
    v_and_b32 v139, v121, v131
    s_waitcnt vmcnt(12)
    v_mfma_f32_16x16x32_bf16 v[140:143], v[132:135], v[48:51], v[140:143]
    s_waitcnt vmcnt(11)
    v_mfma_f32_16x16x32_bf16 v[140:143], v[136:139], v[52:55], v[140:143]
    s_waitcnt vmcnt(7)
    buffer_load_dwordx4 v[100:103], v6, s[40:43], 0 offen offset:1280 nt
    v_and_b32 v132, v122, v128
    v_and_b32 v133, v122, v129
    v_and_b32 v134, v122, v130
    v_and_b32 v135, v122, v131
    v_and_b32 v136, v123, v128
    v_and_b32 v137, v123, v129
    v_and_b32 v138, v123, v130
    v_and_b32 v139, v123, v131
    s_waitcnt vmcnt(11)
    v_mfma_f32_16x16x32_bf16 v[140:143], v[132:135], v[56:59], v[140:143]
    s_waitcnt vmcnt(10)
    v_mfma_f32_16x16x32_bf16 v[140:143], v[136:139], v[60:63], v[140:143]
    s_waitcnt vmcnt(7)
    buffer_load_dwordx4 v[104:107], v6, s[40:43], 0 offen offset:2560 nt
    v_and_b32 v132, v124, v128
    v_and_b32 v133, v124, v129
    v_and_b32 v134, v124, v130
    v_and_b32 v135, v124, v131
    v_and_b32 v136, v125, v128
    v_and_b32 v137, v125, v129
    v_and_b32 v138, v125, v130
    v_and_b32 v139, v125, v131
    s_waitcnt vmcnt(10)
    v_mfma_f32_16x16x32_bf16 v[140:143], v[132:135], v[64:67], v[140:143]
    s_waitcnt vmcnt(9)
    v_mfma_f32_16x16x32_bf16 v[140:143], v[136:139], v[68:71], v[140:143]
    s_waitcnt vmcnt(7)
    buffer_load_dwordx4 v[108:111], v6, s[40:43], 0 offen offset:3840 nt
    v_and_b32 v132, v126, v128
    v_and_b32 v133, v126, v129
    v_and_b32 v134, v126, v130
    v_and_b32 v135, v126, v131
    v_and_b32 v136, v127, v128
    v_and_b32 v137, v127, v129
    v_and_b32 v138, v127, v130
    v_and_b32 v139, v127, v131
    s_waitcnt vmcnt(9)
    v_mfma_f32_16x16x32_bf16 v[140:143], v[132:135], v[72:75], v[140:143]
    s_waitcnt vmcnt(8)
    v_mfma_f32_16x16x32_bf16 v[140:143], v[136:139], v[76:79], v[140:143]
    s_branch L_C_pvdone
L_C_late:
    s_waitcnt vmcnt(7)
    buffer_load_dwordx4 v[80:83], v5, s[40:43], 0 offen offset:0 nt
    s_waitcnt vmcnt(7)
    buffer_load_dwordx4 v[84:87], v5, s[40:43], 0 offen offset:1280 nt
    s_waitcnt vmcnt(7)
    buffer_load_dwordx4 v[88:91], v5, s[40:43], 0 offen offset:2560 nt
    s_waitcnt vmcnt(7)
    buffer_load_dwordx4 v[92:95], v5, s[40:43], 0 offen offset:3840 nt
    s_waitcnt vmcnt(7)
    buffer_load_dwordx4 v[96:99], v6, s[40:43], 0 offen offset:0 nt
    s_waitcnt vmcnt(7)
    buffer_load_dwordx4 v[100:103], v6, s[40:43], 0 offen offset:1280 nt
    s_waitcnt vmcnt(7)
    buffer_load_dwordx4 v[104:107], v6, s[40:43], 0 offen offset:2560 nt
    s_waitcnt vmcnt(7)
    buffer_load_dwordx4 v[108:111], v6, s[40:43], 0 offen offset:3840 nt
    s_mov_b32 s58, 1048576
L_lw_12:
    ds_read_b128 v[148:151], v11 offset:32
    s_waitcnt lgkmcnt(0)
    v_and_b32 v148, v148, v149
    v_and_b32 v150, v150, v151
    v_and_b32 v148, v148, v150
    v_cmp_ne_u32 vcc, 0, v148
    s_cbranch_vccnz L_lwd_13
    s_sub_u32 s58, s58, 1
    s_cbranch_scc1 L_lwd_13
    s_sleep 1
    s_branch L_lw_12
L_lwd_13:
    s_lshl_b32 s52, s27, 8
    v_lshlrev_b32 v12, 6, v2
    v_add_u32 v12, s52, v12
    ds_read_b128 v[112:115], v12 offset:512
    ds_read_b128 v[116:119], v12 offset:528
    ds_read_b128 v[120:123], v12 offset:544
    ds_read_b128 v[124:127], v12 offset:560
    ds_read_b128 v[148:151], v11 offset:384
    ds_read_b128 v[152:155], v11 offset:400
    ds_read_b32 v159, v11 offset:416
    s_waitcnt lgkmcnt(0)
    v_readfirstlane_b32 s57, v159
    v_max_f32 v156, v148, v150
    v_max_f32 v157, v152, v154
    v_max_f32 v156, v156, v157
    v_sub_f32 v148, v148, v156
    v_sub_f32 v150, v150, v156
    v_sub_f32 v152, v152, v156
    v_sub_f32 v154, v154, v156
    v_mul_f32 v148, 0x3fb8aa3b, v148
    v_mul_f32 v150, 0x3fb8aa3b, v150
    v_mul_f32 v152, 0x3fb8aa3b, v152
    v_mul_f32 v154, 0x3fb8aa3b, v154
    v_exp_f32 v148, v148
    v_exp_f32 v150, v150
    v_exp_f32 v152, v152
    v_exp_f32 v154, v154
    v_mul_f32 v157, v148, v149
    v_fmac_f32 v157, v150, v151
    v_fmac_f32 v157, v152, v153
    v_fmac_f32 v157, v154, v155
    v_mov_b32 v158, v148
    s_cmp_eq_u32 s27, 1
    s_cselect_b64 vcc, -1, 0
    v_cndmask_b32 v158, v158, v150, vcc
    s_cmp_eq_u32 s27, 2
    s_cselect_b64 vcc, -1, 0
    v_cndmask_b32 v158, v158, v152, vcc
    s_cmp_eq_u32 s27, 3
    s_cselect_b64 vcc, -1, 0
    v_cndmask_b32 v158, v158, v154, vcc
    v_and_b32 v132, v112, v128
    v_and_b32 v133, v112, v129
    v_and_b32 v134, v112, v130
    v_and_b32 v135, v112, v131
    v_and_b32 v136, v113, v128
    v_and_b32 v137, v113, v129
    v_and_b32 v138, v113, v130
    v_and_b32 v139, v113, v131
    s_waitcnt vmcnt(23)
    v_mfma_f32_16x16x32_bf16 v[140:143], v[132:135], v[16:19], 0
    v_and_b32 v132, v114, v128
    v_and_b32 v133, v114, v129
    v_and_b32 v134, v114, v130
    v_and_b32 v135, v114, v131
    s_waitcnt vmcnt(22)
    v_mfma_f32_16x16x32_bf16 v[140:143], v[136:139], v[20:23], v[140:143]
    v_and_b32 v136, v115, v128
    v_and_b32 v137, v115, v129
    v_and_b32 v138, v115, v130
    v_and_b32 v139, v115, v131
    s_waitcnt vmcnt(21)
    v_mfma_f32_16x16x32_bf16 v[140:143], v[132:135], v[24:27], v[140:143]
    v_and_b32 v132, v116, v128
    v_and_b32 v133, v116, v129
    v_and_b32 v134, v116, v130
    v_and_b32 v135, v116, v131
    s_waitcnt vmcnt(20)
    v_mfma_f32_16x16x32_bf16 v[140:143], v[136:139], v[28:31], v[140:143]
    v_and_b32 v136, v117, v128
    v_and_b32 v137, v117, v129
    v_and_b32 v138, v117, v130
    v_and_b32 v139, v117, v131
    s_waitcnt vmcnt(19)
    v_mfma_f32_16x16x32_bf16 v[140:143], v[132:135], v[32:35], v[140:143]
    v_and_b32 v132, v118, v128
    v_and_b32 v133, v118, v129
    v_and_b32 v134, v118, v130
    v_and_b32 v135, v118, v131
    s_waitcnt vmcnt(18)
    v_mfma_f32_16x16x32_bf16 v[140:143], v[136:139], v[36:39], v[140:143]
    v_and_b32 v136, v119, v128
    v_and_b32 v137, v119, v129
    v_and_b32 v138, v119, v130
    v_and_b32 v139, v119, v131
    s_waitcnt vmcnt(17)
    v_mfma_f32_16x16x32_bf16 v[140:143], v[132:135], v[40:43], v[140:143]
    v_and_b32 v132, v120, v128
    v_and_b32 v133, v120, v129
    v_and_b32 v134, v120, v130
    v_and_b32 v135, v120, v131
    s_waitcnt vmcnt(16)
    v_mfma_f32_16x16x32_bf16 v[140:143], v[136:139], v[44:47], v[140:143]
    v_and_b32 v136, v121, v128
    v_and_b32 v137, v121, v129
    v_and_b32 v138, v121, v130
    v_and_b32 v139, v121, v131
    s_waitcnt vmcnt(15)
    v_mfma_f32_16x16x32_bf16 v[140:143], v[132:135], v[48:51], v[140:143]
    v_and_b32 v132, v122, v128
    v_and_b32 v133, v122, v129
    v_and_b32 v134, v122, v130
    v_and_b32 v135, v122, v131
    s_waitcnt vmcnt(14)
    v_mfma_f32_16x16x32_bf16 v[140:143], v[136:139], v[52:55], v[140:143]
    v_and_b32 v136, v123, v128
    v_and_b32 v137, v123, v129
    v_and_b32 v138, v123, v130
    v_and_b32 v139, v123, v131
    s_waitcnt vmcnt(13)
    v_mfma_f32_16x16x32_bf16 v[140:143], v[132:135], v[56:59], v[140:143]
    v_and_b32 v132, v124, v128
    v_and_b32 v133, v124, v129
    v_and_b32 v134, v124, v130
    v_and_b32 v135, v124, v131
    s_waitcnt vmcnt(12)
    v_mfma_f32_16x16x32_bf16 v[140:143], v[136:139], v[60:63], v[140:143]
    v_and_b32 v136, v125, v128
    v_and_b32 v137, v125, v129
    v_and_b32 v138, v125, v130
    v_and_b32 v139, v125, v131
    s_waitcnt vmcnt(11)
    v_mfma_f32_16x16x32_bf16 v[140:143], v[132:135], v[64:67], v[140:143]
    v_and_b32 v132, v126, v128
    v_and_b32 v133, v126, v129
    v_and_b32 v134, v126, v130
    v_and_b32 v135, v126, v131
    s_waitcnt vmcnt(10)
    v_mfma_f32_16x16x32_bf16 v[140:143], v[136:139], v[68:71], v[140:143]
    v_and_b32 v136, v127, v128
    v_and_b32 v137, v127, v129
    v_and_b32 v138, v127, v130
    v_and_b32 v139, v127, v131
    s_waitcnt vmcnt(9)
    v_mfma_f32_16x16x32_bf16 v[140:143], v[132:135], v[72:75], v[140:143]
    s_waitcnt vmcnt(8)
    v_mfma_f32_16x16x32_bf16 v[140:143], v[136:139], v[76:79], v[140:143]
L_C_pvdone:
    v_cmp_gt_u32 vcc, 32, v0
    s_nop 6
    v_mul_f32 v140, v140, v158
    v_mul_f32 v141, v141, v158
    v_mul_f32 v142, v142, v158
    v_mul_f32 v143, v143, v158
    s_mov_b32 exec_lo, -1
    s_mov_b32 exec_hi, 0
    ds_write_b128 v160, v[140:143] offset:4096
    s_mov_b64 exec, -1
    s_waitcnt lgkmcnt(0)
    s_barrier
    s_cmp_lg_u32 s27, 0
    s_cbranch_scc1 L_C_x2done
    ds_read_b128 v[16:19], v161 offset:4096
    ds_read_b128 v[20:23], v161 offset:4608
    ds_read_b128 v[24:27], v161 offset:5120
    ds_read_b128 v[28:31], v161 offset:5632
    v_mov_b32 v183, v9
    s_mov_b32 s52, 1048576
    s_waitcnt lgkmcnt(2)
    v_pk_add_f32 v[16:17], v[16:17], v[20:21]
    v_pk_add_f32 v[18:19], v[18:19], v[22:23]
    s_waitcnt lgkmcnt(0)
    v_pk_add_f32 v[24:25], v[24:25], v[28:29]
    v_pk_add_f32 v[26:27], v[26:27], v[30:31]
    v_pk_add_f32 v[16:17], v[16:17], v[24:25]
    v_pk_add_f32 v[18:19], v[18:19], v[26:27]
    v_cndmask_b32 v180, v19, v16, vcc
    v_cndmask_b32 v181, v156, v17, vcc
    v_cndmask_b32 v182, v157, v18, vcc
    buffer_store_dwordx4 v[180:183], v162, s[32:35], 0 offen
    s_cmp_eq_u32 s57, 0
    s_cbranch_scc1 L_C_x2done
    buffer_store_dwordx4 v[180:183], v162, s[32:35], s52 offen sc1
L_C_x2done:
    s_barrier
    s_cmp_lt_u32 s29, 5
    s_cbranch_scc0 L_D_ffn
    s_mov_b32 s58, 0
L_D_pl:
    buffer_load_dwordx4 v[16:19], v163, s[32:35], 0 offen sc1
    buffer_load_dwordx4 v[20:23], v163, s[32:35], 0 offen offset:512 sc1
L_D_pl_w:
    s_waitcnt vmcnt(0)
    v_cmp_ne_u32 vcc, v19, v9
    v_cmp_ne_u32 s[52:53], v23, v9
    s_or_b64 vcc, vcc, s[52:53]
    s_cbranch_vccz L_D_pd
    s_add_u32 s58, s58, 1
    s_cmp_lt_u32 s58, 16
    s_cbranch_scc1 L_D_pl
    v_mov_b32 v68, 0
    s_mov_b32 s54, 1048576
L_wb_14:
    ds_read_b32 v64, v68 offset:64
    s_waitcnt lgkmcnt(0)
    v_cmp_ne_u32 vcc, 0, v64
    s_cbranch_vccnz L_wbd_15
    s_sub_u32 s54, s54, 1
    s_cbranch_scc1 L_wbd_15
    s_sleep 1
    s_branch L_wb_14
L_wbd_15:
    ds_read_b128 v[64:67], v3 offset:8192
    v_add_u32 v68, s97, v3
    s_mov_b32 s54, 1048576
    s_waitcnt lgkmcnt(0)
    buffer_store_dwordx4 v[64:67], v68, s[32:35], s54 offen sc1
    s_mov_b32 s61, 1048576
L_D_pl_fb:
    buffer_load_dwordx4 v[56:59], v163, s[32:35], s61 offen sc1
    buffer_load_dwordx4 v[60:63], v163, s[32:35], s61 offen offset:512 sc1
    s_waitcnt vmcnt(0)
    v_cmp_eq_u32 vcc, v59, v9
    s_nop 1
    v_cndmask_b32 v16, v16, v56, vcc
    v_cndmask_b32 v17, v17, v57, vcc
    v_cndmask_b32 v18, v18, v58, vcc
    v_cndmask_b32 v19, v19, v59, vcc
    v_cmp_eq_u32 vcc, v63, v9
    s_nop 1
    v_cndmask_b32 v20, v20, v60, vcc
    v_cndmask_b32 v21, v21, v61, vcc
    v_cndmask_b32 v22, v22, v62, vcc
    v_cndmask_b32 v23, v23, v63, vcc
    v_cmp_ne_u32 vcc, v19, v9
    v_cmp_ne_u32 s[52:53], v23, v9
    s_or_b64 vcc, vcc, s[52:53]
    s_cbranch_vccz L_D_pd
    s_xor_b32 s61, s61, 1048576
    s_add_u32 s58, s58, 1
    s_cmp_lt_u32 s58, 65536
    s_cbranch_scc1 L_D_pl_fb
L_D_pd:
    v_max_f32_dpp v24, v21, v21 row_half_mirror row_mask:0xf bank_mask:0xf
    s_nop 1
    v_max_f32_dpp v24, v24, v24 quad_perm:[1,0,3,2] row_mask:0xf bank_mask:0xf
    s_nop 1
    v_max_f32_dpp v24, v24, v24 quad_perm:[2,3,0,1] row_mask:0xf bank_mask:0xf
    v_sub_f32 v21, v21, v24
    v_mul_f32 v21, 0x3fb8aa3b, v21
    v_exp_f32 v21, v21
    s_nop 0
    v_mul_f32 v22, v22, v21
    v_mul_f32 v16, v16, v21
    v_mul_f32 v17, v17, v21
    v_mul_f32 v18, v18, v21
    v_mul_f32 v20, v20, v21
    v_add_f32_dpp v22, v22, v22 row_half_mirror row_mask:0xf bank_mask:0xf
    v_add_f32_dpp v16, v16, v16 row_half_mirror row_mask:0xf bank_mask:0xf
    v_add_f32_dpp v17, v17, v17 row_half_mirror row_mask:0xf bank_mask:0xf
    v_add_f32_dpp v18, v18, v18 row_half_mirror row_mask:0xf bank_mask:0xf
    v_add_f32_dpp v20, v20, v20 row_half_mirror row_mask:0xf bank_mask:0xf
    v_add_f32_dpp v22, v22, v22 quad_perm:[1,0,3,2] row_mask:0xf bank_mask:0xf
    v_add_f32_dpp v16, v16, v16 quad_perm:[1,0,3,2] row_mask:0xf bank_mask:0xf
    v_add_f32_dpp v17, v17, v17 quad_perm:[1,0,3,2] row_mask:0xf bank_mask:0xf
    v_add_f32_dpp v18, v18, v18 quad_perm:[1,0,3,2] row_mask:0xf bank_mask:0xf
    v_add_f32_dpp v20, v20, v20 quad_perm:[1,0,3,2] row_mask:0xf bank_mask:0xf
    v_add_f32_dpp v22, v22, v22 quad_perm:[2,3,0,1] row_mask:0xf bank_mask:0xf
    v_add_f32_dpp v16, v16, v16 quad_perm:[2,3,0,1] row_mask:0xf bank_mask:0xf
    v_add_f32_dpp v17, v17, v17 quad_perm:[2,3,0,1] row_mask:0xf bank_mask:0xf
    v_add_f32_dpp v18, v18, v18 quad_perm:[2,3,0,1] row_mask:0xf bank_mask:0xf
    v_add_f32_dpp v20, v20, v20 quad_perm:[2,3,0,1] row_mask:0xf bank_mask:0xf
    v_rcp_f32 v22, v22
    s_nop 0
    v_mul_f32 v16, v16, v22
    v_mul_f32 v17, v17, v22
    v_mul_f32 v18, v18, v22
    v_mul_f32 v20, v20, v22
    v_cvt_pk_bf16_f32 v16, v16, v16
    v_cvt_pk_bf16_f32 v17, v17, v17
    v_cvt_pk_bf16_f32 v18, v18, v18
    v_cvt_pk_bf16_f32 v20, v20, v20
    v_and_b32 v24, v16, v128
    v_and_b32 v25, v16, v129
    v_and_b32 v26, v16, v130
    v_and_b32 v27, v16, v131
    v_and_b32 v28, v17, v128
    v_and_b32 v29, v17, v129
    v_and_b32 v30, v17, v130
    v_and_b32 v31, v17, v131
    v_mfma_f32_16x16x32_bf16 v[140:143], v[24:27], v[80:83], 0
    v_and_b32 v32, v18, v128
    v_and_b32 v33, v18, v129
    v_and_b32 v34, v18, v130
    v_and_b32 v35, v18, v131
    v_mfma_f32_16x16x32_bf16 v[140:143], v[28:31], v[84:87], v[140:143]
    v_and_b32 v36, v20, v128
    v_and_b32 v37, v20, v129
    v_and_b32 v38, v20, v130
    v_and_b32 v39, v20, v131
    v_mfma_f32_16x16x32_bf16 v[140:143], v[32:35], v[88:91], v[140:143]
    v_and_b32_dpp v40, v16, v128 row_ror:8 row_mask:0xf bank_mask:0xf
    v_and_b32_dpp v41, v16, v129 row_ror:8 row_mask:0xf bank_mask:0xf
    v_and_b32_dpp v42, v16, v130 row_ror:8 row_mask:0xf bank_mask:0xf
    v_and_b32_dpp v43, v16, v131 row_ror:8 row_mask:0xf bank_mask:0xf
    v_mfma_f32_16x16x32_bf16 v[140:143], v[36:39], v[92:95], v[140:143]
    v_and_b32_dpp v44, v17, v128 row_ror:8 row_mask:0xf bank_mask:0xf
    v_and_b32_dpp v45, v17, v129 row_ror:8 row_mask:0xf bank_mask:0xf
    v_and_b32_dpp v46, v17, v130 row_ror:8 row_mask:0xf bank_mask:0xf
    v_and_b32_dpp v47, v17, v131 row_ror:8 row_mask:0xf bank_mask:0xf
    v_mfma_f32_16x16x32_bf16 v[140:143], v[40:43], v[96:99], v[140:143]
    v_and_b32_dpp v48, v18, v128 row_ror:8 row_mask:0xf bank_mask:0xf
    v_and_b32_dpp v49, v18, v129 row_ror:8 row_mask:0xf bank_mask:0xf
    v_and_b32_dpp v50, v18, v130 row_ror:8 row_mask:0xf bank_mask:0xf
    v_and_b32_dpp v51, v18, v131 row_ror:8 row_mask:0xf bank_mask:0xf
    v_mfma_f32_16x16x32_bf16 v[140:143], v[44:47], v[100:103], v[140:143]
    v_and_b32_dpp v52, v20, v128 row_ror:8 row_mask:0xf bank_mask:0xf
    v_and_b32_dpp v53, v20, v129 row_ror:8 row_mask:0xf bank_mask:0xf
    v_and_b32_dpp v54, v20, v130 row_ror:8 row_mask:0xf bank_mask:0xf
    v_and_b32_dpp v55, v20, v131 row_ror:8 row_mask:0xf bank_mask:0xf
    v_mfma_f32_16x16x32_bf16 v[140:143], v[48:51], v[104:107], v[140:143]
    s_nop 0
    v_mfma_f32_16x16x32_bf16 v[140:143], v[52:55], v[108:111], v[140:143]
    s_branch L_D_red
L_D_ffn:
    s_cmp_eq_u32 s62, 0
    s_cbranch_scc1 L_final
    v_and_b32_dpp v24, v176, v128 row_newbcast:0 row_mask:0xf bank_mask:0xf
    v_and_b32_dpp v25, v176, v129 row_newbcast:0 row_mask:0xf bank_mask:0xf
    v_and_b32_dpp v26, v176, v130 row_newbcast:0 row_mask:0xf bank_mask:0xf
    v_and_b32_dpp v27, v176, v131 row_newbcast:0 row_mask:0xf bank_mask:0xf
    v_and_b32_dpp v28, v177, v128 row_newbcast:0 row_mask:0xf bank_mask:0xf
    v_and_b32_dpp v29, v177, v129 row_newbcast:0 row_mask:0xf bank_mask:0xf
    v_and_b32_dpp v30, v177, v130 row_newbcast:0 row_mask:0xf bank_mask:0xf
    v_and_b32_dpp v31, v177, v131 row_newbcast:0 row_mask:0xf bank_mask:0xf
    v_and_b32_dpp v32, v176, v128 row_newbcast:1 row_mask:0xf bank_mask:0xf
    v_and_b32_dpp v33, v176, v129 row_newbcast:1 row_mask:0xf bank_mask:0xf
    v_and_b32_dpp v34, v176, v130 row_newbcast:1 row_mask:0xf bank_mask:0xf
    v_and_b32_dpp v35, v176, v131 row_newbcast:1 row_mask:0xf bank_mask:0xf
    v_and_b32_dpp v36, v177, v128 row_newbcast:1 row_mask:0xf bank_mask:0xf
    v_and_b32_dpp v37, v177, v129 row_newbcast:1 row_mask:0xf bank_mask:0xf
    v_and_b32_dpp v38, v177, v130 row_newbcast:1 row_mask:0xf bank_mask:0xf
    v_and_b32_dpp v39, v177, v131 row_newbcast:1 row_mask:0xf bank_mask:0xf
    v_and_b32_dpp v40, v176, v128 row_newbcast:2 row_mask:0xf bank_mask:0xf
    v_and_b32_dpp v41, v176, v129 row_newbcast:2 row_mask:0xf bank_mask:0xf
    v_and_b32_dpp v42, v176, v130 row_newbcast:2 row_mask:0xf bank_mask:0xf
    v_and_b32_dpp v43, v176, v131 row_newbcast:2 row_mask:0xf bank_mask:0xf
    v_and_b32_dpp v44, v177, v128 row_newbcast:2 row_mask:0xf bank_mask:0xf
    v_and_b32_dpp v45, v177, v129 row_newbcast:2 row_mask:0xf bank_mask:0xf
    v_and_b32_dpp v46, v177, v130 row_newbcast:2 row_mask:0xf bank_mask:0xf
    v_and_b32_dpp v47, v177, v131 row_newbcast:2 row_mask:0xf bank_mask:0xf
    v_and_b32_dpp v48, v176, v128 row_newbcast:3 row_mask:0xf bank_mask:0xf
    v_and_b32_dpp v49, v176, v129 row_newbcast:3 row_mask:0xf bank_mask:0xf
    v_and_b32_dpp v50, v176, v130 row_newbcast:3 row_mask:0xf bank_mask:0xf
    v_and_b32_dpp v51, v176, v131 row_newbcast:3 row_mask:0xf bank_mask:0xf
    v_and_b32_dpp v52, v177, v128 row_newbcast:3 row_mask:0xf bank_mask:0xf
    v_and_b32_dpp v53, v177, v129 row_newbcast:3 row_mask:0xf bank_mask:0xf
    v_and_b32_dpp v54, v177, v130 row_newbcast:3 row_mask:0xf bank_mask:0xf
    v_and_b32_dpp v55, v177, v131 row_newbcast:3 row_mask:0xf bank_mask:0xf
    s_waitcnt vmcnt(0)
    v_mfma_f32_16x16x32_bf16 v[140:143], v[24:27], v[80:83], 0
    v_mfma_f32_16x16x32_bf16 v[140:143], v[28:31], v[84:87], v[140:143]
    v_mfma_f32_16x16x32_bf16 v[140:143], v[32:35], v[88:91], v[140:143]
    v_mfma_f32_16x16x32_bf16 v[140:143], v[36:39], v[92:95], v[140:143]
    v_mfma_f32_16x16x32_bf16 v[140:143], v[40:43], v[96:99], v[140:143]
    v_mfma_f32_16x16x32_bf16 v[140:143], v[44:47], v[100:103], v[140:143]
    v_mfma_f32_16x16x32_bf16 v[140:143], v[48:51], v[104:107], v[140:143]
    v_mfma_f32_16x16x32_bf16 v[140:143], v[52:55], v[108:111], v[140:143]
L_D_red:
    s_mov_b32 exec_lo, -1
    s_mov_b32 exec_hi, 0
    s_nop 6
    ds_write_b128 v164, v[140:143] offset:6144
    s_mov_b64 exec, -1
    s_waitcnt lgkmcnt(0)
    s_barrier
    s_cmp_lg_u32 s27, 0
    s_cbranch_scc1 L_final
    ds_read_b64 v[16:17], v165 offset:6144
    ds_read_b64 v[18:19], v165 offset:6656
    ds_read_b64 v[20:21], v165 offset:7168
    ds_read_b64 v[22:23], v165 offset:7680
    v_mov_b32 v26, 0
    v_mov_b32 v27, v9
    s_waitcnt lgkmcnt(0)
    v_pk_add_f32 v[16:17], v[16:17], v[18:19]
    v_pk_add_f32 v[20:21], v[20:21], v[22:23]
    v_pk_add_f32 v[24:25], v[16:17], v[20:21]
    buffer_store_dwordx4 v[24:27], v166, s[32:35], 0 offen sc1
    s_cmp_lt_u32 s29, 5
    s_cbranch_scc1 L_final
    s_cmp_eq_u32 s56, 0
    s_cbranch_scc1 L_final
    v_mov_b32 v68, 0
    s_mov_b32 s54, 1048576
L_wb_16:
    ds_read_b32 v64, v68 offset:64
    s_waitcnt lgkmcnt(0)
    v_cmp_ne_u32 vcc, 0, v64
    s_cbranch_vccnz L_wbd_17
    s_sub_u32 s54, s54, 1
    s_cbranch_scc1 L_wbd_17
    s_sleep 1
    s_branch L_wb_16
L_wbd_17:
    ds_read_b128 v[64:67], v3 offset:8192
    v_add_u32 v68, s97, v3
    s_mov_b32 s54, 1048576
    s_waitcnt lgkmcnt(0)
    buffer_store_dwordx4 v[64:67], v68, s[32:35], s54 offen sc1
L_final:
    s_cmp_lt_u32 s2, 160
    s_cbranch_scc0 L_CD_end
    s_cmp_eq_u32 s27, 0
    s_cbranch_scc0 L_CD_end
    s_mov_b32 s58, 0
L_RF_pl:
    buffer_load_dwordx4 v[40:43], v168, s[32:35], 0 offen sc1
L_RF_pl_w:
    s_waitcnt vmcnt(0)
    v_cmp_ne_u32 vcc, v43, v9
    s_cbranch_vccz L_RF_pd
    s_add_u32 s58, s58, 1
    s_cmp_lt_u32 s58, 65536
    s_cbranch_scc1 L_RF_pl
L_RF_pd:
    buffer_load_dwordx4 v[44:47], v167, s[32:35], 0 offen sc1
    v_cmp_gt_u32 vcc, 14, v169
    s_nop 1
    v_cndmask_b32 v40, 0, v40, vcc
    v_cndmask_b32 v41, 0, v41, vcc
    s_nop 0
    v_add_f32_dpp v40, v40, v40 row_ror:2 row_mask:0xf bank_mask:0xf
    v_add_f32_dpp v41, v41, v41 row_ror:2 row_mask:0xf bank_mask:0xf
    s_nop 0
    v_add_f32_dpp v40, v40, v40 row_ror:4 row_mask:0xf bank_mask:0xf
    v_add_f32_dpp v41, v41, v41 row_ror:4 row_mask:0xf bank_mask:0xf
    s_nop 0
    v_add_f32_dpp v40, v40, v40 row_ror:8 row_mask:0xf bank_mask:0xf
    v_add_f32_dpp v41, v41, v41 row_ror:8 row_mask:0xf bank_mask:0xf
    v_mov_b32 v48, v40
    v_mov_b32 v49, v41
    s_nop 0
    v_permlane16_swap_b32 v40, v48
    v_permlane16_swap_b32 v41, v49
    v_add_f32 v40, v40, v48
    v_add_f32 v41, v41, v49
    v_mov_b32 v48, v40
    v_mov_b32 v49, v41
    s_nop 0
    v_permlane32_swap_b32 v40, v48
    v_permlane32_swap_b32 v41, v49
    v_add_f32 v40, v40, v48
    v_add_f32 v41, v41, v49
    v_cvt_pk_bf16_f32 v40, v40, v41
    v_lshlrev_b32 v50, 16, v40
    v_and_b32 v51, 0xffff0000, v40
    v_lshlrev_b32 v52, 16, v8
    v_and_b32 v53, 0xffff0000, v8
    s_mov_b32 s58, 0
    s_branch L_RA_w
L_RA_pl:
    buffer_load_dwordx4 v[44:47], v167, s[32:35], 0 offen sc1
L_RA_w:
    s_waitcnt vmcnt(0)
    v_cmp_ne_u32 vcc, v47, v9
    s_cbranch_vccz L_RA_pd
    s_add_u32 s58, s58, 1
    s_cmp_lt_u32 s58, 65536
    s_cbranch_scc1 L_RA_pl
L_RA_pd:
    v_add_f32_dpp v44, v44, v44 row_ror:2 row_mask:0xf bank_mask:0xf
    v_add_f32_dpp v45, v45, v45 row_ror:2 row_mask:0xf bank_mask:0xf
    s_nop 0
    v_add_f32_dpp v44, v44, v44 row_ror:4 row_mask:0xf bank_mask:0xf
    v_add_f32_dpp v45, v45, v45 row_ror:4 row_mask:0xf bank_mask:0xf
    s_nop 0
    v_add_f32_dpp v44, v44, v44 row_ror:8 row_mask:0xf bank_mask:0xf
    v_add_f32_dpp v45, v45, v45 row_ror:8 row_mask:0xf bank_mask:0xf
    v_mov_b32 v48, v44
    v_mov_b32 v49, v45
    s_nop 0
    v_permlane16_swap_b32 v44, v48
    v_permlane16_swap_b32 v45, v49
    v_add_f32 v44, v44, v48
    v_add_f32 v45, v45, v49
    v_mov_b32 v48, v44
    v_mov_b32 v49, v45
    s_nop 0
    v_permlane32_swap_b32 v44, v48
    v_permlane32_swap_b32 v45, v49
    v_add_f32 v44, v44, v48
    v_add_f32 v45, v45, v49
    v_cvt_pk_bf16_f32 v44, v44, v45
    v_lshlrev_b32 v54, 16, v44
    v_and_b32 v55, 0xffff0000, v44
    v_pk_add_f32 v[52:53], v[52:53], v[54:55]
    v_cvt_pk_bf16_f32 v52, v52, v53
    v_lshlrev_b32 v54, 16, v52
    v_and_b32 v55, 0xffff0000, v52
    v_pk_add_f32 v[54:55], v[54:55], v[50:51]
    v_cvt_pk_bf16_f32 v54, v54, v55
    s_mov_b64 exec, 3
    buffer_store_dword v54, v10, s[48:51], 0 offen
    s_cmp_eq_u32 s2, 0
    s_cbranch_scc0 L_CD_end
    s_mov_b64 exec, 1
    buffer_store_dword v9, off, s[32:35], 0 sc1
L_CD_end:
L_end:
    s_endpgm
.section .rodata,"a"
.p2align 6
.amdhsa_kernel parallel_sum__sliding_block_cached__dense_activation_silu__decode_kernel
  .amdhsa_next_free_vgpr 192
  .amdhsa_next_free_sgpr 102
  .amdhsa_accum_offset 192
  .amdhsa_group_segment_fixed_size 0
  .amdhsa_kernarg_size 88
  .amdhsa_user_sgpr_count 2
  .amdhsa_user_sgpr_kernarg_segment_ptr 1
  .amdhsa_system_sgpr_workgroup_id_x 1
  .amdhsa_float_denorm_mode_32 3
.end_amdhsa_kernel
```
